```python
import torch

def _softmax(x, axis=-1):
    return torch.softmax(x, dim=axis)
def _gelu(x):
    return torch.nn.functional.gelu(x, approximate="tanh")
def _silu(x):
    return torch.nn.functional.silu(x)
def _sigmoid(x):
    return torch.sigmoid(x)
def _layernorm(x, axis=-1, eps=1e-5):
    m = x.mean(dim=axis, keepdim=True)
    v = x.var(dim=axis, keepdim=True, unbiased=False)
    return (x - m) / torch.sqrt(v + eps)
def _scatter_add(tgt, idx, src, axis=0):
    return tgt.clone().index_add_(axis, idx, src)
def _segment_sum(src, seg, n):
    out = torch.zeros((n,) + src.shape[1:], dtype=src.dtype)
    return out.index_add_(0, seg, src)
def _pad(x, pw):
    flat = tuple(v for pair in reversed(pw) for v in pair)
    return torch.nn.functional.pad(x, flat)

kernel_name = 'standalone__gqa_softmax__decode'

def setup_inputs():

    _w = (lambda a: (lambda t: t.to(torch.bfloat16) if t.is_floating_point() else t)(torch.as_tensor(a)))
    B, Hq, Hkv, Sq, Sk, D = 2, 32, 4, 1, 32768, 128
    return {
        "q": _w((lambda *s: torch.randn(*s, dtype=torch.bfloat16) * 0.8)(B, Hq, Sq, D)),
        "k": _w((lambda *s: torch.randn(*s, dtype=torch.bfloat16) * 0.8)(B, Hkv, Sk, D)),
        "v": _w((lambda *s: torch.randn(*s, dtype=torch.bfloat16) * 0.05)(B, Hkv, Sk, D)),
    }

def reference(q, k, v):
    B, Hq, Sq, D = q.shape
    Hkv = k.shape[1]
    rep = Hq // Hkv
    k = (lambda x, n, axis: torch.repeat_interleave(x, n, dim=axis))(k, rep, axis=1)
    v = (lambda x, n, axis: torch.repeat_interleave(x, n, dim=axis))(v, rep, axis=1)
    scale = D ** -0.5
    scores = torch.einsum("bhqd,bhkd->bhqk", q, k) * scale
    p = _softmax(scores, axis=-1)
    return torch.einsum("bhqk,bhkd->bhqd", p, v)
```

```asm
; @launch grid=(256,1,1) block=(256,1,1) lds=98720
.amdgcn_target "amdgcn-amd-amdhsa--gfx950"
.text
.globl standalone__gqa_softmax__decode_kernel
.p2align 8
.type standalone__gqa_softmax__decode_kernel,@function
standalone__gqa_softmax__decode_kernel:
    s_cmp_ge_u32 s2, 256
    s_cbranch_scc1 L_end
    s_load_dwordx8 s[4:11], s[0:1], 0
    s_load_dwordx4 s[12:15], s[0:1], 32
    v_lshrrev_b32 v2, 6, v0
    v_and_b32 v1, 63, v0
    s_and_b32 s39, s2, 7
    v_readfirstlane_b32 s38, v2
    s_lshr_b32 s40, s2, 3
    s_lshl_b32 s42, s39, 23
    s_lshl_b32 s3, s40, 18
    s_add_u32 s42, s42, s3
    v_lshrrev_b32 v2, 4, v1
    v_and_b32 v3, 15, v1
    s_lshl_b32 s3, s38, 12
    s_add_u32 s42, s42, s3
    s_mul_i32 s41, s38, 24576
    v_xor_b32 v9, v2, v3
    v_lshlrev_b32 v9, 4, v9
    v_lshl_or_b32 v9, v2, 8, v9
    v_add_u32 v10, s42, v9
    v_xor_b32 v11, 64, v10
    v_xor_b32 v12, 128, v10
    v_xor_b32 v13, 192, v10
    v_and_b32 v4, 7, v1
    v_lshlrev_b32 v4, 8, v4
    v_lshl_or_b32 v4, v2, 4, v4
    s_lshl_b32 s3, s39, 11
    v_add_u32 v4, s3, v4
    s_lshl_b32 s46, s39, 5
    s_add_u32 s46, s46, s40
    s_mul_i32 s3, s46, 4352
    v_lshl_add_u32 v6, v0, 4, s3
    s_add_u32 s3, s3, 4096
    v_lshl_add_u32 v7, v1, 4, s3
    v_mov_b32 v244, -1
    v_mov_b32 v245, -1
    v_mov_b32 v246, -1
    v_mov_b32 v247, -1
    s_waitcnt lgkmcnt(0)
    s_mov_b32 s16, s6
    s_mov_b32 s17, s7
    s_mov_b32 s18, 67108864
    s_mov_b32 s19, 0x00020000
    s_add_u32 m0, s41, 0
    s_mov_b32 s36, 0
    buffer_load_dwordx4 v10, s[16:19], s36 offen offset:0 nt lds
    buffer_load_dwordx4 v11, s[16:19], s36 offen offset:1024 nt lds
    buffer_load_dwordx4 v12, s[16:19], s36 offen offset:2048 nt lds
    buffer_load_dwordx4 v13, s[16:19], s36 offen offset:3072 nt lds
    s_mov_b32 s24, s4
    s_mov_b32 s25, s5
    s_mov_b32 s26, 16384
    s_mov_b32 s27, 0x00020000
    buffer_load_dwordx4 v[28:31], v4, s[24:27], 0 offen offset:0
    buffer_load_dwordx4 v[32:35], v4, s[24:27], 0 offen offset:64
    buffer_load_dwordx4 v[36:39], v4, s[24:27], 0 offen offset:128
    buffer_load_dwordx4 v[40:43], v4, s[24:27], 0 offen offset:192
    s_mov_b32 s28, s14
    s_mov_b32 s29, s15
    s_mov_b32 s30, 4194304
    s_mov_b32 s31, 0x00020000
    s_cmp_lg_u32 s38, 0
    s_cbranch_scc1 L_w1
    buffer_store_dwordx4 v[244:247], v6, s[28:31], 0 offen offset:0
    buffer_store_dwordx4 v[244:247], v6, s[28:31], 0 offen offset:1024
    buffer_store_dwordx4 v[244:247], v6, s[28:31], 0 offen offset:2048
    buffer_store_dwordx4 v[244:247], v6, s[28:31], 0 offen offset:3072
    s_mov_b64 exec, 0xff
    buffer_store_dwordx4 v[244:247], v7, s[28:31], 0 offen
    s_mov_b64 exec, -1
L_w1:
    s_add_u32 m0, s41, 4096
    s_mov_b32 s36, 16384
    buffer_load_dwordx4 v10, s[16:19], s36 offen offset:0 nt lds
    buffer_load_dwordx4 v11, s[16:19], s36 offen offset:1024 nt lds
    buffer_load_dwordx4 v12, s[16:19], s36 offen offset:2048 nt lds
    buffer_load_dwordx4 v13, s[16:19], s36 offen offset:3072 nt lds
    s_add_u32 m0, s41, 8192
    s_mov_b32 s36, 32768
    buffer_load_dwordx4 v10, s[16:19], s36 offen offset:0 nt lds
    buffer_load_dwordx4 v11, s[16:19], s36 offen offset:1024 nt lds
    buffer_load_dwordx4 v12, s[16:19], s36 offen offset:2048 nt lds
    buffer_load_dwordx4 v13, s[16:19], s36 offen offset:3072 nt lds
    s_add_u32 m0, s41, 12288
    s_mov_b32 s36, 49152
    buffer_load_dwordx4 v10, s[16:19], s36 offen offset:0 nt lds
    buffer_load_dwordx4 v11, s[16:19], s36 offen offset:1024 nt lds
    buffer_load_dwordx4 v12, s[16:19], s36 offen offset:2048 nt lds
    buffer_load_dwordx4 v13, s[16:19], s36 offen offset:3072 nt lds
    s_add_u32 m0, s41, 16384
    s_mov_b32 s36, 65536
    buffer_load_dwordx4 v10, s[16:19], s36 offen offset:0 nt lds
    buffer_load_dwordx4 v11, s[16:19], s36 offen offset:1024 nt lds
    buffer_load_dwordx4 v12, s[16:19], s36 offen offset:2048 nt lds
    buffer_load_dwordx4 v13, s[16:19], s36 offen offset:3072 nt lds
    s_add_u32 m0, s41, 20480
    s_mov_b32 s36, 81920
    buffer_load_dwordx4 v10, s[16:19], s36 offen offset:0 nt lds
    buffer_load_dwordx4 v11, s[16:19], s36 offen offset:1024 nt lds
    buffer_load_dwordx4 v12, s[16:19], s36 offen offset:2048 nt lds
    buffer_load_dwordx4 v13, s[16:19], s36 offen offset:3072 nt lds
    v_lshlrev_b32 v9, 1, v2
    v_xor_b32 v9, v9, v3
    v_lshlrev_b32 v9, 4, v9
    v_lshl_or_b32 v9, v2, 8, v9
    v_add_u32 v14, s42, v9
    v_xor_b32 v15, 128, v14
    s_mov_b32 s20, s8
    s_mov_b32 s21, s9
    s_mov_b32 s22, 67108864
    s_mov_b32 s23, 0x00020000
    s_mov_b32 s32, s10
    s_mov_b32 s33, s11
    s_mov_b32 s34, 16384
    s_mov_b32 s35, 0x00020000
    v_xor_b32 v9, v2, v3
    v_lshlrev_b32 v9, 4, v9
    v_lshl_or_b32 v9, v3, 8, v9
    v_xor_b32 v16, 0, v9
    v_add_u32 v16, s41, v16
    v_xor_b32 v17, 64, v9
    v_add_u32 v17, s41, v17
    v_xor_b32 v18, 128, v9
    v_add_u32 v18, s41, v18
    v_xor_b32 v19, 192, v9
    v_add_u32 v19, s41, v19
    v_lshrrev_b32 v9, 2, v1
    v_and_b32 v5, 7, v9
    v_lshlrev_b32 v5, 5, v5
    v_lshl_or_b32 v5, v9, 8, v5
    v_and_b32 v9, 3, v1
    v_lshl_or_b32 v5, v9, 3, v5
    v_xor_b32 v20, 0, v5
    v_add_u32 v20, s41, v20
    v_xor_b32 v21, 32, v5
    v_add_u32 v21, s41, v21
    v_xor_b32 v22, 64, v5
    v_add_u32 v22, s41, v22
    v_xor_b32 v23, 96, v5
    v_add_u32 v23, s41, v23
    v_xor_b32 v24, 128, v5
    v_add_u32 v24, s41, v24
    v_xor_b32 v25, 160, v5
    v_add_u32 v25, s41, v25
    v_xor_b32 v26, 192, v5
    v_add_u32 v26, s41, v26
    v_xor_b32 v27, 224, v5
    v_add_u32 v27, s41, v27
    v_mov_b32 v240, 0x3f803f80
    v_mov_b32 v241, 0x3f803f80
    v_mov_b32 v242, 0x3f803f80
    v_mov_b32 v243, 0x3f803f80
    s_mov_b32 s37, 0x3fb8aa3b
    s_mov_b32 s44, 0xff00ff00
    s_mov_b32 s45, 0xff00ff00
    s_lshl_b32 s3, s39, 4
    v_mov_b32 v8, s3
    s_getreg_b32 s47, hwreg(HW_REG_XCC_ID, 0, 3)
    s_lshl_b32 s47, s47, 3
    v_and_b32 v250, 7, v1
    v_mul_u32_u24 v250, 528, v250
    v_bfe_u32 v9, v1, 3, 1
    v_lshl_add_u32 v250, v9, 8, v250
    v_lshl_add_u32 v250, v2, 4, v250
    v_add_u32 v250, s41, v250
    v_add_u32 v250, 8192, v250
    v_lshrrev_b32 v251, 5, v0
    v_mul_u32_u24 v251, 528, v251
    v_and_b32 v9, 31, v1
    v_lshl_add_u32 v251, v9, 4, v251
    v_lshlrev_b32 v253, 4, v3
    v_add_u32 v253, 98304, v253
    s_lshl_b32 s3, s38, 2
    v_add_u32 v252, s3, v253
    s_and_b32 s54, s40, 7
    s_mul_i32 s3, s39, 139264
    v_lshrrev_b32 v9, 3, v1
    v_mul_u32_u24 v9, 4352, v9
    v_add_u32 v9, s3, v9
    s_lshl_b32 s3, s54, 9
    s_lshl_b32 s48, s38, 7
    s_add_u32 s3, s3, s48
    v_and_b32 v246, 7, v1
    v_lshl_add_u32 v254, v246, 4, v9
    v_add_u32 v254, s3, v254
    s_lshl_b32 s3, s54, 4
    s_add_u32 s3, s3, 4096
    v_add_u32 v255, s3, v9
    s_lshl_b32 s3, s39, 3
    s_add_u32 s3, s3, s54
    s_lshl_b32 s3, s3, 8
    s_lshl_b32 s48, s38, 6
    s_add_u32 s3, s3, s48
    v_lshlrev_b32 v246, 3, v246
    v_lshl_or_b32 v246, v2, 1, v246
    v_add_u32 v246, s3, v246
    s_mov_b32 s50, 0
    s_mov_b32 s51, 34816
    s_mov_b32 s52, 69632
    s_mov_b32 s53, 104448
    v_mov_b32 v3, 98304
    s_mov_b32 s55, 0x3db504f3
    s_waitcnt vmcnt(20)
    ds_read_b128 v[108:111], v16 offset:0
    ds_read_b128 v[112:115], v17 offset:0
    ds_read_b128 v[116:119], v18 offset:0
    ds_read_b128 v[120:123], v19 offset:0
    s_waitcnt lgkmcnt(3)
    v_mfma_f32_16x16x32_bf16 v[44:47], v[108:111], v[28:31], 0
    s_waitcnt lgkmcnt(2)
    v_mfma_f32_16x16x32_bf16 v[44:47], v[112:115], v[32:35], v[44:47]
    s_waitcnt lgkmcnt(1)
    v_mfma_f32_16x16x32_bf16 v[44:47], v[116:119], v[36:39], v[44:47]
    s_waitcnt lgkmcnt(0)
    v_mfma_f32_16x16x32_bf16 v[44:47], v[120:123], v[40:43], v[44:47]
    s_add_u32 m0, s41, 0
    s_mov_b32 s36, 98304
    buffer_load_dwordx4 v10, s[16:19], s36 offen offset:0 nt lds
    buffer_load_dwordx4 v11, s[16:19], s36 offen offset:1024 nt lds
    buffer_load_dwordx4 v12, s[16:19], s36 offen offset:2048 nt lds
    buffer_load_dwordx4 v13, s[16:19], s36 offen offset:3072 nt lds
    s_waitcnt vmcnt(20)
    ds_read_b128 v[124:127], v16 offset:4096
    ds_read_b128 v[128:131], v17 offset:4096
    ds_read_b128 v[132:135], v18 offset:4096
    ds_read_b128 v[136:139], v19 offset:4096
    v_cvt_pk_bf16_f32 v44, 0, v44
    v_cvt_pk_bf16_f32 v45, 0, v45
    v_cvt_pk_bf16_f32 v46, 0, v46
    v_cvt_pk_bf16_f32 v47, 0, v47
    v_mul_f32 v44, s55, v44
    v_mul_f32 v45, s55, v45
    v_mul_f32 v46, s55, v46
    v_mul_f32 v47, s55, v47
    v_cvt_pk_bf16_f32 v44, 0, v44
    v_cvt_pk_bf16_f32 v45, 0, v45
    v_cvt_pk_bf16_f32 v46, 0, v46
    v_cvt_pk_bf16_f32 v47, 0, v47
    s_waitcnt lgkmcnt(3)
    v_mfma_f32_16x16x32_bf16 v[48:51], v[124:127], v[28:31], 0
    s_waitcnt lgkmcnt(2)
    v_mfma_f32_16x16x32_bf16 v[48:51], v[128:131], v[32:35], v[48:51]
    s_waitcnt lgkmcnt(1)
    v_mfma_f32_16x16x32_bf16 v[48:51], v[132:135], v[36:39], v[48:51]
    s_waitcnt lgkmcnt(0)
    v_mfma_f32_16x16x32_bf16 v[48:51], v[136:139], v[40:43], v[48:51]
    s_add_u32 m0, s41, 4096
    s_mov_b32 s36, 114688
    buffer_load_dwordx4 v10, s[16:19], s36 offen offset:0 nt lds
    buffer_load_dwordx4 v11, s[16:19], s36 offen offset:1024 nt lds
    buffer_load_dwordx4 v12, s[16:19], s36 offen offset:2048 nt lds
    buffer_load_dwordx4 v13, s[16:19], s36 offen offset:3072 nt lds
    s_waitcnt vmcnt(20)
    ds_read_b128 v[108:111], v16 offset:8192
    ds_read_b128 v[112:115], v17 offset:8192
    ds_read_b128 v[116:119], v18 offset:8192
    ds_read_b128 v[120:123], v19 offset:8192
    v_cvt_pk_bf16_f32 v48, 0, v48
    v_cvt_pk_bf16_f32 v49, 0, v49
    v_cvt_pk_bf16_f32 v50, 0, v50
    v_cvt_pk_bf16_f32 v51, 0, v51
    v_mul_f32 v48, s55, v48
    v_mul_f32 v49, s55, v49
    v_mul_f32 v50, s55, v50
    v_mul_f32 v51, s55, v51
    v_cvt_pk_bf16_f32 v48, 0, v48
    v_cvt_pk_bf16_f32 v49, 0, v49
    v_cvt_pk_bf16_f32 v50, 0, v50
    v_cvt_pk_bf16_f32 v51, 0, v51
    s_waitcnt lgkmcnt(3)
    v_mfma_f32_16x16x32_bf16 v[52:55], v[108:111], v[28:31], 0
    s_waitcnt lgkmcnt(2)
    v_mfma_f32_16x16x32_bf16 v[52:55], v[112:115], v[32:35], v[52:55]
    s_waitcnt lgkmcnt(1)
    v_mfma_f32_16x16x32_bf16 v[52:55], v[116:119], v[36:39], v[52:55]
    s_waitcnt lgkmcnt(0)
    v_mfma_f32_16x16x32_bf16 v[52:55], v[120:123], v[40:43], v[52:55]
    s_add_u32 m0, s41, 8192
    s_mov_b32 s36, 131072
    buffer_load_dwordx4 v10, s[16:19], s36 offen offset:0 nt lds
    buffer_load_dwordx4 v11, s[16:19], s36 offen offset:1024 nt lds
    buffer_load_dwordx4 v12, s[16:19], s36 offen offset:2048 nt lds
    buffer_load_dwordx4 v13, s[16:19], s36 offen offset:3072 nt lds
    s_waitcnt vmcnt(20)
    ds_read_b128 v[124:127], v16 offset:12288
    ds_read_b128 v[128:131], v17 offset:12288
    ds_read_b128 v[132:135], v18 offset:12288
    ds_read_b128 v[136:139], v19 offset:12288
    v_cvt_pk_bf16_f32 v52, 0, v52
    v_cvt_pk_bf16_f32 v53, 0, v53
    v_cvt_pk_bf16_f32 v54, 0, v54
    v_cvt_pk_bf16_f32 v55, 0, v55
    v_mul_f32 v52, s55, v52
    v_mul_f32 v53, s55, v53
    v_mul_f32 v54, s55, v54
    v_mul_f32 v55, s55, v55
    v_cvt_pk_bf16_f32 v52, 0, v52
    v_cvt_pk_bf16_f32 v53, 0, v53
    v_cvt_pk_bf16_f32 v54, 0, v54
    v_cvt_pk_bf16_f32 v55, 0, v55
    s_waitcnt lgkmcnt(3)
    v_mfma_f32_16x16x32_bf16 v[56:59], v[124:127], v[28:31], 0
    s_waitcnt lgkmcnt(2)
    v_mfma_f32_16x16x32_bf16 v[56:59], v[128:131], v[32:35], v[56:59]
    s_waitcnt lgkmcnt(1)
    v_mfma_f32_16x16x32_bf16 v[56:59], v[132:135], v[36:39], v[56:59]
    s_waitcnt lgkmcnt(0)
    v_mfma_f32_16x16x32_bf16 v[56:59], v[136:139], v[40:43], v[56:59]
    s_add_u32 m0, s41, 12288
    s_mov_b32 s36, 147456
    buffer_load_dwordx4 v10, s[16:19], s36 offen offset:0 nt lds
    buffer_load_dwordx4 v11, s[16:19], s36 offen offset:1024 nt lds
    buffer_load_dwordx4 v12, s[16:19], s36 offen offset:2048 nt lds
    buffer_load_dwordx4 v13, s[16:19], s36 offen offset:3072 nt lds
    s_waitcnt vmcnt(20)
    ds_read_b128 v[108:111], v16 offset:16384
    ds_read_b128 v[112:115], v17 offset:16384
    ds_read_b128 v[116:119], v18 offset:16384
    ds_read_b128 v[120:123], v19 offset:16384
    v_cvt_pk_bf16_f32 v56, 0, v56
    v_cvt_pk_bf16_f32 v57, 0, v57
    v_cvt_pk_bf16_f32 v58, 0, v58
    v_cvt_pk_bf16_f32 v59, 0, v59
    v_mul_f32 v56, s55, v56
    v_mul_f32 v57, s55, v57
    v_mul_f32 v58, s55, v58
    v_mul_f32 v59, s55, v59
    v_cvt_pk_bf16_f32 v56, 0, v56
    v_cvt_pk_bf16_f32 v57, 0, v57
    v_cvt_pk_bf16_f32 v58, 0, v58
    v_cvt_pk_bf16_f32 v59, 0, v59
    s_waitcnt lgkmcnt(3)
    v_mfma_f32_16x16x32_bf16 v[60:63], v[108:111], v[28:31], 0
    s_waitcnt lgkmcnt(2)
    v_mfma_f32_16x16x32_bf16 v[60:63], v[112:115], v[32:35], v[60:63]
    s_waitcnt lgkmcnt(1)
    v_mfma_f32_16x16x32_bf16 v[60:63], v[116:119], v[36:39], v[60:63]
    s_waitcnt lgkmcnt(0)
    v_mfma_f32_16x16x32_bf16 v[60:63], v[120:123], v[40:43], v[60:63]
    s_add_u32 m0, s41, 16384
    s_mov_b32 s36, 163840
    buffer_load_dwordx4 v10, s[16:19], s36 offen offset:0 nt lds
    buffer_load_dwordx4 v11, s[16:19], s36 offen offset:1024 nt lds
    buffer_load_dwordx4 v12, s[16:19], s36 offen offset:2048 nt lds
    buffer_load_dwordx4 v13, s[16:19], s36 offen offset:3072 nt lds
    s_waitcnt vmcnt(20)
    ds_read_b128 v[124:127], v16 offset:20480
    ds_read_b128 v[128:131], v17 offset:20480
    ds_read_b128 v[132:135], v18 offset:20480
    ds_read_b128 v[136:139], v19 offset:20480
    v_cvt_pk_bf16_f32 v60, 0, v60
    v_cvt_pk_bf16_f32 v61, 0, v61
    v_cvt_pk_bf16_f32 v62, 0, v62
    v_cvt_pk_bf16_f32 v63, 0, v63
    v_mul_f32 v60, s55, v60
    v_mul_f32 v61, s55, v61
    v_mul_f32 v62, s55, v62
    v_mul_f32 v63, s55, v63
    v_cvt_pk_bf16_f32 v60, 0, v60
    v_cvt_pk_bf16_f32 v61, 0, v61
    v_cvt_pk_bf16_f32 v62, 0, v62
    v_cvt_pk_bf16_f32 v63, 0, v63
    s_waitcnt lgkmcnt(3)
    v_mfma_f32_16x16x32_bf16 v[64:67], v[124:127], v[28:31], 0
    s_waitcnt lgkmcnt(2)
    v_mfma_f32_16x16x32_bf16 v[64:67], v[128:131], v[32:35], v[64:67]
    s_waitcnt lgkmcnt(1)
    v_mfma_f32_16x16x32_bf16 v[64:67], v[132:135], v[36:39], v[64:67]
    s_waitcnt lgkmcnt(0)
    v_mfma_f32_16x16x32_bf16 v[64:67], v[136:139], v[40:43], v[64:67]
    s_add_u32 m0, s41, 20480
    s_mov_b32 s36, 180224
    buffer_load_dwordx4 v10, s[16:19], s36 offen offset:0 nt lds
    buffer_load_dwordx4 v11, s[16:19], s36 offen offset:1024 nt lds
    buffer_load_dwordx4 v12, s[16:19], s36 offen offset:2048 nt lds
    buffer_load_dwordx4 v13, s[16:19], s36 offen offset:3072 nt lds
    s_waitcnt vmcnt(20)
    ds_read_b128 v[108:111], v16 offset:0
    ds_read_b128 v[112:115], v17 offset:0
    ds_read_b128 v[116:119], v18 offset:0
    ds_read_b128 v[120:123], v19 offset:0
    v_cvt_pk_bf16_f32 v64, 0, v64
    v_cvt_pk_bf16_f32 v65, 0, v65
    v_cvt_pk_bf16_f32 v66, 0, v66
    v_cvt_pk_bf16_f32 v67, 0, v67
    v_mul_f32 v64, s55, v64
    v_mul_f32 v65, s55, v65
    v_mul_f32 v66, s55, v66
    v_mul_f32 v67, s55, v67
    v_cvt_pk_bf16_f32 v64, 0, v64
    v_cvt_pk_bf16_f32 v65, 0, v65
    v_cvt_pk_bf16_f32 v66, 0, v66
    v_cvt_pk_bf16_f32 v67, 0, v67
    s_waitcnt lgkmcnt(3)
    v_mfma_f32_16x16x32_bf16 v[68:71], v[108:111], v[28:31], 0
    s_waitcnt lgkmcnt(2)
    v_mfma_f32_16x16x32_bf16 v[68:71], v[112:115], v[32:35], v[68:71]
    s_waitcnt lgkmcnt(1)
    v_mfma_f32_16x16x32_bf16 v[68:71], v[116:119], v[36:39], v[68:71]
    s_waitcnt lgkmcnt(0)
    v_mfma_f32_16x16x32_bf16 v[68:71], v[120:123], v[40:43], v[68:71]
    s_add_u32 m0, s41, 0
    s_mov_b32 s36, 196608
    buffer_load_dwordx4 v10, s[16:19], s36 offen offset:0 nt lds
    buffer_load_dwordx4 v11, s[16:19], s36 offen offset:1024 nt lds
    buffer_load_dwordx4 v12, s[16:19], s36 offen offset:2048 nt lds
    buffer_load_dwordx4 v13, s[16:19], s36 offen offset:3072 nt lds
    s_waitcnt vmcnt(20)
    ds_read_b128 v[124:127], v16 offset:4096
    ds_read_b128 v[128:131], v17 offset:4096
    ds_read_b128 v[132:135], v18 offset:4096
    ds_read_b128 v[136:139], v19 offset:4096
    v_cvt_pk_bf16_f32 v68, 0, v68
    v_cvt_pk_bf16_f32 v69, 0, v69
    v_cvt_pk_bf16_f32 v70, 0, v70
    v_cvt_pk_bf16_f32 v71, 0, v71
    v_mul_f32 v68, s55, v68
    v_mul_f32 v69, s55, v69
    v_mul_f32 v70, s55, v70
    v_mul_f32 v71, s55, v71
    v_cvt_pk_bf16_f32 v68, 0, v68
    v_cvt_pk_bf16_f32 v69, 0, v69
    v_cvt_pk_bf16_f32 v70, 0, v70
    v_cvt_pk_bf16_f32 v71, 0, v71
    s_waitcnt lgkmcnt(3)
    v_mfma_f32_16x16x32_bf16 v[72:75], v[124:127], v[28:31], 0
    s_waitcnt lgkmcnt(2)
    v_mfma_f32_16x16x32_bf16 v[72:75], v[128:131], v[32:35], v[72:75]
    s_waitcnt lgkmcnt(1)
    v_mfma_f32_16x16x32_bf16 v[72:75], v[132:135], v[36:39], v[72:75]
    s_waitcnt lgkmcnt(0)
    v_mfma_f32_16x16x32_bf16 v[72:75], v[136:139], v[40:43], v[72:75]
    s_add_u32 m0, s41, 4096
    s_mov_b32 s36, 212992
    buffer_load_dwordx4 v10, s[16:19], s36 offen offset:0 nt lds
    buffer_load_dwordx4 v11, s[16:19], s36 offen offset:1024 nt lds
    buffer_load_dwordx4 v12, s[16:19], s36 offen offset:2048 nt lds
    buffer_load_dwordx4 v13, s[16:19], s36 offen offset:3072 nt lds
    s_waitcnt vmcnt(20)
    ds_read_b128 v[108:111], v16 offset:8192
    ds_read_b128 v[112:115], v17 offset:8192
    ds_read_b128 v[116:119], v18 offset:8192
    ds_read_b128 v[120:123], v19 offset:8192
    v_cvt_pk_bf16_f32 v72, 0, v72
    v_cvt_pk_bf16_f32 v73, 0, v73
    v_cvt_pk_bf16_f32 v74, 0, v74
    v_cvt_pk_bf16_f32 v75, 0, v75
    v_mul_f32 v72, s55, v72
    v_mul_f32 v73, s55, v73
    v_mul_f32 v74, s55, v74
    v_mul_f32 v75, s55, v75
    v_cvt_pk_bf16_f32 v72, 0, v72
    v_cvt_pk_bf16_f32 v73, 0, v73
    v_cvt_pk_bf16_f32 v74, 0, v74
    v_cvt_pk_bf16_f32 v75, 0, v75
    s_waitcnt lgkmcnt(3)
    v_mfma_f32_16x16x32_bf16 v[76:79], v[108:111], v[28:31], 0
    s_waitcnt lgkmcnt(2)
    v_mfma_f32_16x16x32_bf16 v[76:79], v[112:115], v[32:35], v[76:79]
    s_waitcnt lgkmcnt(1)
    v_mfma_f32_16x16x32_bf16 v[76:79], v[116:119], v[36:39], v[76:79]
    s_waitcnt lgkmcnt(0)
    v_mfma_f32_16x16x32_bf16 v[76:79], v[120:123], v[40:43], v[76:79]
    s_add_u32 m0, s41, 8192
    s_mov_b32 s36, 229376
    buffer_load_dwordx4 v10, s[16:19], s36 offen offset:0 nt lds
    buffer_load_dwordx4 v11, s[16:19], s36 offen offset:1024 nt lds
    buffer_load_dwordx4 v12, s[16:19], s36 offen offset:2048 nt lds
    buffer_load_dwordx4 v13, s[16:19], s36 offen offset:3072 nt lds
    s_waitcnt vmcnt(20)
    ds_read_b128 v[124:127], v16 offset:12288
    ds_read_b128 v[128:131], v17 offset:12288
    ds_read_b128 v[132:135], v18 offset:12288
    ds_read_b128 v[136:139], v19 offset:12288
    v_cvt_pk_bf16_f32 v76, 0, v76
    v_cvt_pk_bf16_f32 v77, 0, v77
    v_cvt_pk_bf16_f32 v78, 0, v78
    v_cvt_pk_bf16_f32 v79, 0, v79
    v_mul_f32 v76, s55, v76
    v_mul_f32 v77, s55, v77
    v_mul_f32 v78, s55, v78
    v_mul_f32 v79, s55, v79
    v_cvt_pk_bf16_f32 v76, 0, v76
    v_cvt_pk_bf16_f32 v77, 0, v77
    v_cvt_pk_bf16_f32 v78, 0, v78
    v_cvt_pk_bf16_f32 v79, 0, v79
    s_waitcnt lgkmcnt(3)
    v_mfma_f32_16x16x32_bf16 v[80:83], v[124:127], v[28:31], 0
    s_waitcnt lgkmcnt(2)
    v_mfma_f32_16x16x32_bf16 v[80:83], v[128:131], v[32:35], v[80:83]
    s_waitcnt lgkmcnt(1)
    v_mfma_f32_16x16x32_bf16 v[80:83], v[132:135], v[36:39], v[80:83]
    s_waitcnt lgkmcnt(0)
    v_mfma_f32_16x16x32_bf16 v[80:83], v[136:139], v[40:43], v[80:83]
    s_add_u32 m0, s41, 12288
    s_mov_b32 s36, 245760
    buffer_load_dwordx4 v10, s[16:19], s36 offen offset:0 nt lds
    buffer_load_dwordx4 v11, s[16:19], s36 offen offset:1024 nt lds
    buffer_load_dwordx4 v12, s[16:19], s36 offen offset:2048 nt lds
    buffer_load_dwordx4 v13, s[16:19], s36 offen offset:3072 nt lds
    s_waitcnt vmcnt(20)
    ds_read_b128 v[108:111], v16 offset:16384
    ds_read_b128 v[112:115], v17 offset:16384
    ds_read_b128 v[116:119], v18 offset:16384
    ds_read_b128 v[120:123], v19 offset:16384
    v_cvt_pk_bf16_f32 v80, 0, v80
    v_cvt_pk_bf16_f32 v81, 0, v81
    v_cvt_pk_bf16_f32 v82, 0, v82
    v_cvt_pk_bf16_f32 v83, 0, v83
    v_mul_f32 v80, s55, v80
    v_mul_f32 v81, s55, v81
    v_mul_f32 v82, s55, v82
    v_mul_f32 v83, s55, v83
    v_cvt_pk_bf16_f32 v80, 0, v80
    v_cvt_pk_bf16_f32 v81, 0, v81
    v_cvt_pk_bf16_f32 v82, 0, v82
    v_cvt_pk_bf16_f32 v83, 0, v83
    s_waitcnt lgkmcnt(3)
    v_mfma_f32_16x16x32_bf16 v[84:87], v[108:111], v[28:31], 0
    s_waitcnt lgkmcnt(2)
    v_mfma_f32_16x16x32_bf16 v[84:87], v[112:115], v[32:35], v[84:87]
    s_waitcnt lgkmcnt(1)
    v_mfma_f32_16x16x32_bf16 v[84:87], v[116:119], v[36:39], v[84:87]
    s_waitcnt lgkmcnt(0)
    v_mfma_f32_16x16x32_bf16 v[84:87], v[120:123], v[40:43], v[84:87]
    s_add_u32 m0, s41, 16384
    s_mov_b32 s36, 0
    buffer_load_dwordx4 v14, s[20:23], s36 offen offset:0 nt lds
    buffer_load_dwordx4 v15, s[20:23], s36 offen offset:1024 nt lds
    buffer_load_dwordx4 v14, s[20:23], s36 offen offset:2048 nt lds
    buffer_load_dwordx4 v15, s[20:23], s36 offen offset:3072 nt lds
    s_waitcnt vmcnt(20)
    ds_read_b128 v[124:127], v16 offset:20480
    ds_read_b128 v[128:131], v17 offset:20480
    ds_read_b128 v[132:135], v18 offset:20480
    ds_read_b128 v[136:139], v19 offset:20480
    v_cvt_pk_bf16_f32 v84, 0, v84
    v_cvt_pk_bf16_f32 v85, 0, v85
    v_cvt_pk_bf16_f32 v86, 0, v86
    v_cvt_pk_bf16_f32 v87, 0, v87
    v_mul_f32 v84, s55, v84
    v_mul_f32 v85, s55, v85
    v_mul_f32 v86, s55, v86
    v_mul_f32 v87, s55, v87
    v_cvt_pk_bf16_f32 v84, 0, v84
    v_cvt_pk_bf16_f32 v85, 0, v85
    v_cvt_pk_bf16_f32 v86, 0, v86
    v_cvt_pk_bf16_f32 v87, 0, v87
    s_waitcnt lgkmcnt(3)
    v_mfma_f32_16x16x32_bf16 v[88:91], v[124:127], v[28:31], 0
    s_waitcnt lgkmcnt(2)
    v_mfma_f32_16x16x32_bf16 v[88:91], v[128:131], v[32:35], v[88:91]
    s_waitcnt lgkmcnt(1)
    v_mfma_f32_16x16x32_bf16 v[88:91], v[132:135], v[36:39], v[88:91]
    s_waitcnt lgkmcnt(0)
    v_mfma_f32_16x16x32_bf16 v[88:91], v[136:139], v[40:43], v[88:91]
    s_add_u32 m0, s41, 20480
    s_mov_b32 s36, 16384
    buffer_load_dwordx4 v14, s[20:23], s36 offen offset:0 nt lds
    buffer_load_dwordx4 v15, s[20:23], s36 offen offset:1024 nt lds
    buffer_load_dwordx4 v14, s[20:23], s36 offen offset:2048 nt lds
    buffer_load_dwordx4 v15, s[20:23], s36 offen offset:3072 nt lds
    s_waitcnt vmcnt(20)
    ds_read_b128 v[108:111], v16 offset:0
    ds_read_b128 v[112:115], v17 offset:0
    ds_read_b128 v[116:119], v18 offset:0
    ds_read_b128 v[120:123], v19 offset:0
    v_cvt_pk_bf16_f32 v88, 0, v88
    v_cvt_pk_bf16_f32 v89, 0, v89
    v_cvt_pk_bf16_f32 v90, 0, v90
    v_cvt_pk_bf16_f32 v91, 0, v91
    v_mul_f32 v88, s55, v88
    v_mul_f32 v89, s55, v89
    v_mul_f32 v90, s55, v90
    v_mul_f32 v91, s55, v91
    v_cvt_pk_bf16_f32 v88, 0, v88
    v_cvt_pk_bf16_f32 v89, 0, v89
    v_cvt_pk_bf16_f32 v90, 0, v90
    v_cvt_pk_bf16_f32 v91, 0, v91
    s_waitcnt lgkmcnt(3)
    v_mfma_f32_16x16x32_bf16 v[92:95], v[108:111], v[28:31], 0
    s_waitcnt lgkmcnt(2)
    v_mfma_f32_16x16x32_bf16 v[92:95], v[112:115], v[32:35], v[92:95]
    s_waitcnt lgkmcnt(1)
    v_mfma_f32_16x16x32_bf16 v[92:95], v[116:119], v[36:39], v[92:95]
    s_waitcnt lgkmcnt(0)
    v_mfma_f32_16x16x32_bf16 v[92:95], v[120:123], v[40:43], v[92:95]
    s_add_u32 m0, s41, 0
    s_mov_b32 s36, 32768
    buffer_load_dwordx4 v14, s[20:23], s36 offen offset:0 nt lds
    buffer_load_dwordx4 v15, s[20:23], s36 offen offset:1024 nt lds
    buffer_load_dwordx4 v14, s[20:23], s36 offen offset:2048 nt lds
    buffer_load_dwordx4 v15, s[20:23], s36 offen offset:3072 nt lds
    s_waitcnt vmcnt(20)
    ds_read_b128 v[124:127], v16 offset:4096
    ds_read_b128 v[128:131], v17 offset:4096
    ds_read_b128 v[132:135], v18 offset:4096
    ds_read_b128 v[136:139], v19 offset:4096
    v_cvt_pk_bf16_f32 v92, 0, v92
    v_cvt_pk_bf16_f32 v93, 0, v93
    v_cvt_pk_bf16_f32 v94, 0, v94
    v_cvt_pk_bf16_f32 v95, 0, v95
    v_mul_f32 v92, s55, v92
    v_mul_f32 v93, s55, v93
    v_mul_f32 v94, s55, v94
    v_mul_f32 v95, s55, v95
    v_cvt_pk_bf16_f32 v92, 0, v92
    v_cvt_pk_bf16_f32 v93, 0, v93
    v_cvt_pk_bf16_f32 v94, 0, v94
    v_cvt_pk_bf16_f32 v95, 0, v95
    s_waitcnt lgkmcnt(3)
    v_mfma_f32_16x16x32_bf16 v[96:99], v[124:127], v[28:31], 0
    s_waitcnt lgkmcnt(2)
    v_mfma_f32_16x16x32_bf16 v[96:99], v[128:131], v[32:35], v[96:99]
    s_waitcnt lgkmcnt(1)
    v_mfma_f32_16x16x32_bf16 v[96:99], v[132:135], v[36:39], v[96:99]
    s_waitcnt lgkmcnt(0)
    v_mfma_f32_16x16x32_bf16 v[96:99], v[136:139], v[40:43], v[96:99]
    s_add_u32 m0, s41, 4096
    s_mov_b32 s36, 49152
    buffer_load_dwordx4 v14, s[20:23], s36 offen offset:0 nt lds
    buffer_load_dwordx4 v15, s[20:23], s36 offen offset:1024 nt lds
    buffer_load_dwordx4 v14, s[20:23], s36 offen offset:2048 nt lds
    buffer_load_dwordx4 v15, s[20:23], s36 offen offset:3072 nt lds
    s_waitcnt vmcnt(20)
    ds_read_b128 v[108:111], v16 offset:8192
    ds_read_b128 v[112:115], v17 offset:8192
    ds_read_b128 v[116:119], v18 offset:8192
    ds_read_b128 v[120:123], v19 offset:8192
    v_cvt_pk_bf16_f32 v96, 0, v96
    v_cvt_pk_bf16_f32 v97, 0, v97
    v_cvt_pk_bf16_f32 v98, 0, v98
    v_cvt_pk_bf16_f32 v99, 0, v99
    v_mul_f32 v96, s55, v96
    v_mul_f32 v97, s55, v97
    v_mul_f32 v98, s55, v98
    v_mul_f32 v99, s55, v99
    v_cvt_pk_bf16_f32 v96, 0, v96
    v_cvt_pk_bf16_f32 v97, 0, v97
    v_cvt_pk_bf16_f32 v98, 0, v98
    v_cvt_pk_bf16_f32 v99, 0, v99
    s_waitcnt lgkmcnt(3)
    v_mfma_f32_16x16x32_bf16 v[100:103], v[108:111], v[28:31], 0
    s_waitcnt lgkmcnt(2)
    v_mfma_f32_16x16x32_bf16 v[100:103], v[112:115], v[32:35], v[100:103]
    s_waitcnt lgkmcnt(1)
    v_mfma_f32_16x16x32_bf16 v[100:103], v[116:119], v[36:39], v[100:103]
    s_waitcnt lgkmcnt(0)
    v_mfma_f32_16x16x32_bf16 v[100:103], v[120:123], v[40:43], v[100:103]
    s_add_u32 m0, s41, 8192
    s_mov_b32 s36, 65536
    buffer_load_dwordx4 v14, s[20:23], s36 offen offset:0 nt lds
    buffer_load_dwordx4 v15, s[20:23], s36 offen offset:1024 nt lds
    buffer_load_dwordx4 v14, s[20:23], s36 offen offset:2048 nt lds
    buffer_load_dwordx4 v15, s[20:23], s36 offen offset:3072 nt lds
    s_waitcnt vmcnt(20)
    ds_read_b128 v[124:127], v16 offset:12288
    ds_read_b128 v[128:131], v17 offset:12288
    ds_read_b128 v[132:135], v18 offset:12288
    ds_read_b128 v[136:139], v19 offset:12288
    v_cvt_pk_bf16_f32 v100, 0, v100
    v_cvt_pk_bf16_f32 v101, 0, v101
    v_cvt_pk_bf16_f32 v102, 0, v102
    v_cvt_pk_bf16_f32 v103, 0, v103
    v_mul_f32 v100, s55, v100
    v_mul_f32 v101, s55, v101
    v_mul_f32 v102, s55, v102
    v_mul_f32 v103, s55, v103
    v_cvt_pk_bf16_f32 v100, 0, v100
    v_cvt_pk_bf16_f32 v101, 0, v101
    v_cvt_pk_bf16_f32 v102, 0, v102
    v_cvt_pk_bf16_f32 v103, 0, v103
    s_waitcnt lgkmcnt(3)
    v_mfma_f32_16x16x32_bf16 v[104:107], v[124:127], v[28:31], 0
    s_waitcnt lgkmcnt(2)
    v_mfma_f32_16x16x32_bf16 v[104:107], v[128:131], v[32:35], v[104:107]
    s_waitcnt lgkmcnt(1)
    v_mfma_f32_16x16x32_bf16 v[104:107], v[132:135], v[36:39], v[104:107]
    s_waitcnt lgkmcnt(0)
    v_mfma_f32_16x16x32_bf16 v[104:107], v[136:139], v[40:43], v[104:107]
    s_add_u32 m0, s41, 12288
    s_mov_b32 s36, 81920
    buffer_load_dwordx4 v14, s[20:23], s36 offen offset:0 nt lds
    buffer_load_dwordx4 v15, s[20:23], s36 offen offset:1024 nt lds
    buffer_load_dwordx4 v14, s[20:23], s36 offen offset:2048 nt lds
    buffer_load_dwordx4 v15, s[20:23], s36 offen offset:3072 nt lds
    s_nop 1
    v_cvt_pk_bf16_f32 v104, 0, v104
    v_cvt_pk_bf16_f32 v105, 0, v105
    v_cvt_pk_bf16_f32 v106, 0, v106
    v_cvt_pk_bf16_f32 v107, 0, v107
    v_mul_f32 v104, s55, v104
    v_mul_f32 v105, s55, v105
    v_mul_f32 v106, s55, v106
    v_mul_f32 v107, s55, v107
    v_cvt_pk_bf16_f32 v104, 0, v104
    v_cvt_pk_bf16_f32 v105, 0, v105
    v_cvt_pk_bf16_f32 v106, 0, v106
    v_cvt_pk_bf16_f32 v107, 0, v107
    v_max3_f32 v4, v44, v45, v46
    v_max3_f32 v9, v47, v48, v49
    v_max3_f32 v4, v4, v50, v51
    v_max3_f32 v9, v9, v52, v53
    v_max3_f32 v4, v4, v54, v55
    v_max3_f32 v9, v9, v56, v57
    v_max3_f32 v4, v4, v58, v59
    v_max3_f32 v9, v9, v60, v61
    v_max3_f32 v4, v4, v62, v63
    v_max3_f32 v9, v9, v64, v65
    v_max3_f32 v4, v4, v66, v67
    v_max3_f32 v9, v9, v68, v69
    v_max3_f32 v4, v4, v70, v71
    v_max3_f32 v9, v9, v72, v73
    v_max3_f32 v4, v4, v74, v75
    v_max3_f32 v9, v9, v76, v77
    v_max3_f32 v4, v4, v78, v79
    v_max3_f32 v9, v9, v80, v81
    v_max3_f32 v4, v4, v82, v83
    v_max3_f32 v9, v9, v84, v85
    v_max3_f32 v4, v4, v86, v87
    v_max3_f32 v9, v9, v88, v89
    v_max3_f32 v4, v4, v90, v91
    v_max3_f32 v9, v9, v92, v93
    v_max3_f32 v4, v4, v94, v95
    v_max3_f32 v9, v9, v96, v97
    v_max3_f32 v4, v4, v98, v99
    v_max3_f32 v9, v9, v100, v101
    v_max3_f32 v4, v4, v102, v103
    v_max3_f32 v9, v9, v104, v105
    v_max3_f32 v4, v4, v106, v107
    v_max_f32 v4, v4, v9
    v_mov_b32 v9, v4
    s_nop 1
    v_permlane32_swap_b32 v9, v4
    v_max_f32 v4, v4, v9
    v_mov_b32 v9, v4
    s_nop 1
    v_permlane16_swap_b32 v9, v4
    v_max_f32 v4, v4, v9
    s_mov_b64 exec, 0xffff
    ds_write_b32 v252, v4
    s_mov_b64 exec, -1
    v_add_u32 v31, 81920, v251
    s_waitcnt lgkmcnt(0)
    s_barrier
    ds_read_b128 v[108:111], v253
    s_cmp_lg_u32 s38, 0
    s_cbranch_scc1 L_w2
    s_mov_b64 s[48:49], 1
    s_lshl_b64 s[48:49], s[48:49], s47
    v_mov_b32 v248, s48
    v_mov_b32 v249, s49
    s_mov_b64 exec, 1
    global_atomic_add_x2 v8, v[248:249], s[12:13]
    s_mov_b64 exec, -1
L_w2:
    s_waitcnt lgkmcnt(0)
    v_max3_f32 v4, v108, v109, v110
    v_max_f32 v4, v4, v111
    v_mul_f32 v5, s37, v4
    v_fma_f32 v44, v44, s37, -v5
    v_fma_f32 v45, v45, s37, -v5
    v_fma_f32 v46, v46, s37, -v5
    v_fma_f32 v47, v47, s37, -v5
    v_fma_f32 v48, v48, s37, -v5
    v_fma_f32 v49, v49, s37, -v5
    v_fma_f32 v50, v50, s37, -v5
    v_fma_f32 v51, v51, s37, -v5
    v_exp_f32 v44, v44
    v_exp_f32 v45, v45
    v_exp_f32 v46, v46
    v_exp_f32 v47, v47
    v_exp_f32 v48, v48
    v_exp_f32 v49, v49
    v_exp_f32 v50, v50
    v_exp_f32 v51, v51
    s_nop 0
    v_cvt_pk_bf16_f32 v44, v44, v45
    v_cvt_pk_bf16_f32 v45, v46, v47
    v_cvt_pk_bf16_f32 v46, v48, v49
    v_cvt_pk_bf16_f32 v47, v50, v51
    v_fma_f32 v52, v52, s37, -v5
    v_fma_f32 v53, v53, s37, -v5
    v_fma_f32 v54, v54, s37, -v5
    v_fma_f32 v55, v55, s37, -v5
    v_fma_f32 v56, v56, s37, -v5
    v_fma_f32 v57, v57, s37, -v5
    v_fma_f32 v58, v58, s37, -v5
    v_fma_f32 v59, v59, s37, -v5
    v_exp_f32 v52, v52
    v_exp_f32 v53, v53
    v_exp_f32 v54, v54
    v_exp_f32 v55, v55
    v_exp_f32 v56, v56
    v_exp_f32 v57, v57
    v_exp_f32 v58, v58
    v_exp_f32 v59, v59
    v_mfma_f32_16x16x32_bf16 v[236:239], v[240:243], v[44:47], 0
    v_cvt_pk_bf16_f32 v52, v52, v53
    v_cvt_pk_bf16_f32 v53, v54, v55
    v_cvt_pk_bf16_f32 v54, v56, v57
    v_cvt_pk_bf16_f32 v55, v58, v59
    v_fma_f32 v60, v60, s37, -v5
    v_fma_f32 v61, v61, s37, -v5
    v_fma_f32 v62, v62, s37, -v5
    v_fma_f32 v63, v63, s37, -v5
    v_fma_f32 v64, v64, s37, -v5
    v_fma_f32 v65, v65, s37, -v5
    v_fma_f32 v66, v66, s37, -v5
    v_fma_f32 v67, v67, s37, -v5
    v_exp_f32 v60, v60
    v_exp_f32 v61, v61
    v_exp_f32 v62, v62
    v_exp_f32 v63, v63
    v_exp_f32 v64, v64
    v_exp_f32 v65, v65
    v_exp_f32 v66, v66
    v_exp_f32 v67, v67
    v_mfma_f32_16x16x32_bf16 v[236:239], v[240:243], v[52:55], v[236:239]
    v_cvt_pk_bf16_f32 v60, v60, v61
    v_cvt_pk_bf16_f32 v61, v62, v63
    v_cvt_pk_bf16_f32 v62, v64, v65
    v_cvt_pk_bf16_f32 v63, v66, v67
    v_fma_f32 v68, v68, s37, -v5
    v_fma_f32 v69, v69, s37, -v5
    v_fma_f32 v70, v70, s37, -v5
    v_fma_f32 v71, v71, s37, -v5
    v_fma_f32 v72, v72, s37, -v5
    v_fma_f32 v73, v73, s37, -v5
    v_fma_f32 v74, v74, s37, -v5
    v_fma_f32 v75, v75, s37, -v5
    v_exp_f32 v68, v68
    v_exp_f32 v69, v69
    v_exp_f32 v70, v70
    v_exp_f32 v71, v71
    v_exp_f32 v72, v72
    v_exp_f32 v73, v73
    v_exp_f32 v74, v74
    v_exp_f32 v75, v75
    v_mfma_f32_16x16x32_bf16 v[236:239], v[240:243], v[60:63], v[236:239]
    v_cvt_pk_bf16_f32 v68, v68, v69
    v_cvt_pk_bf16_f32 v69, v70, v71
    v_cvt_pk_bf16_f32 v70, v72, v73
    v_cvt_pk_bf16_f32 v71, v74, v75
    v_fma_f32 v76, v76, s37, -v5
    v_fma_f32 v77, v77, s37, -v5
    v_fma_f32 v78, v78, s37, -v5
    v_fma_f32 v79, v79, s37, -v5
    v_fma_f32 v80, v80, s37, -v5
    v_fma_f32 v81, v81, s37, -v5
    v_fma_f32 v82, v82, s37, -v5
    v_fma_f32 v83, v83, s37, -v5
    v_exp_f32 v76, v76
    v_exp_f32 v77, v77
    v_exp_f32 v78, v78
    v_exp_f32 v79, v79
    v_exp_f32 v80, v80
    v_exp_f32 v81, v81
    v_exp_f32 v82, v82
    v_exp_f32 v83, v83
    v_mfma_f32_16x16x32_bf16 v[236:239], v[240:243], v[68:71], v[236:239]
    v_cvt_pk_bf16_f32 v76, v76, v77
    v_cvt_pk_bf16_f32 v77, v78, v79
    v_cvt_pk_bf16_f32 v78, v80, v81
    v_cvt_pk_bf16_f32 v79, v82, v83
    v_fma_f32 v84, v84, s37, -v5
    v_fma_f32 v85, v85, s37, -v5
    v_fma_f32 v86, v86, s37, -v5
    v_fma_f32 v87, v87, s37, -v5
    v_fma_f32 v88, v88, s37, -v5
    v_fma_f32 v89, v89, s37, -v5
    v_fma_f32 v90, v90, s37, -v5
    v_fma_f32 v91, v91, s37, -v5
    v_exp_f32 v84, v84
    v_exp_f32 v85, v85
    v_exp_f32 v86, v86
    v_exp_f32 v87, v87
    v_exp_f32 v88, v88
    v_exp_f32 v89, v89
    v_exp_f32 v90, v90
    v_exp_f32 v91, v91
    v_mfma_f32_16x16x32_bf16 v[236:239], v[240:243], v[76:79], v[236:239]
    v_cvt_pk_bf16_f32 v84, v84, v85
    v_cvt_pk_bf16_f32 v85, v86, v87
    v_cvt_pk_bf16_f32 v86, v88, v89
    v_cvt_pk_bf16_f32 v87, v90, v91
    v_fma_f32 v92, v92, s37, -v5
    v_fma_f32 v93, v93, s37, -v5
    v_fma_f32 v94, v94, s37, -v5
    v_fma_f32 v95, v95, s37, -v5
    v_fma_f32 v96, v96, s37, -v5
    v_fma_f32 v97, v97, s37, -v5
    v_fma_f32 v98, v98, s37, -v5
    v_fma_f32 v99, v99, s37, -v5
    v_exp_f32 v92, v92
    v_exp_f32 v93, v93
    v_exp_f32 v94, v94
    v_exp_f32 v95, v95
    v_exp_f32 v96, v96
    v_exp_f32 v97, v97
    v_exp_f32 v98, v98
    v_exp_f32 v99, v99
    v_mfma_f32_16x16x32_bf16 v[236:239], v[240:243], v[84:87], v[236:239]
    v_cvt_pk_bf16_f32 v92, v92, v93
    v_cvt_pk_bf16_f32 v93, v94, v95
    v_cvt_pk_bf16_f32 v94, v96, v97
    v_cvt_pk_bf16_f32 v95, v98, v99
    v_fma_f32 v100, v100, s37, -v5
    v_fma_f32 v101, v101, s37, -v5
    v_fma_f32 v102, v102, s37, -v5
    v_fma_f32 v103, v103, s37, -v5
    v_fma_f32 v104, v104, s37, -v5
    v_fma_f32 v105, v105, s37, -v5
    v_fma_f32 v106, v106, s37, -v5
    v_fma_f32 v107, v107, s37, -v5
    v_exp_f32 v100, v100
    v_exp_f32 v101, v101
    v_exp_f32 v102, v102
    v_exp_f32 v103, v103
    v_exp_f32 v104, v104
    v_exp_f32 v105, v105
    v_exp_f32 v106, v106
    v_exp_f32 v107, v107
    v_mfma_f32_16x16x32_bf16 v[236:239], v[240:243], v[92:95], v[236:239]
    v_cvt_pk_bf16_f32 v100, v100, v101
    v_cvt_pk_bf16_f32 v101, v102, v103
    v_cvt_pk_bf16_f32 v102, v104, v105
    v_cvt_pk_bf16_f32 v103, v106, v107
    s_nop 1
    v_mfma_f32_16x16x32_bf16 v[236:239], v[240:243], v[100:103], v[236:239]
    s_waitcnt vmcnt(20)
    ds_read_b64_tr_b16 v[140:141], v20 offset:16384
    ds_read_b64_tr_b16 v[144:145], v21 offset:16384
    ds_read_b64_tr_b16 v[148:149], v22 offset:16384
    ds_read_b64_tr_b16 v[152:153], v23 offset:16384
    ds_read_b64_tr_b16 v[156:157], v24 offset:16384
    ds_read_b64_tr_b16 v[160:161], v25 offset:16384
    ds_read_b64_tr_b16 v[164:165], v26 offset:16384
    ds_read_b64_tr_b16 v[168:169], v27 offset:16384
    s_waitcnt vmcnt(16)
    ds_read_b64_tr_b16 v[142:143], v20 offset:20480
    ds_read_b64_tr_b16 v[146:147], v21 offset:20480
    ds_read_b64_tr_b16 v[150:151], v22 offset:20480
    ds_read_b64_tr_b16 v[154:155], v23 offset:20480
    ds_read_b64_tr_b16 v[158:159], v24 offset:20480
    ds_read_b64_tr_b16 v[162:163], v25 offset:20480
    ds_read_b64_tr_b16 v[166:167], v26 offset:20480
    ds_read_b64_tr_b16 v[170:171], v27 offset:20480
    s_waitcnt lgkmcnt(7)
    v_mfma_f32_16x16x32_bf16 v[204:207], v[140:143], v[44:47], 0
    s_waitcnt lgkmcnt(6)
    v_mfma_f32_16x16x32_bf16 v[208:211], v[144:147], v[44:47], 0
    s_waitcnt lgkmcnt(5)
    v_mfma_f32_16x16x32_bf16 v[212:215], v[148:151], v[44:47], 0
    s_waitcnt lgkmcnt(4)
    v_mfma_f32_16x16x32_bf16 v[216:219], v[152:155], v[44:47], 0
    s_waitcnt lgkmcnt(3)
    v_mfma_f32_16x16x32_bf16 v[220:223], v[156:159], v[44:47], 0
    s_waitcnt lgkmcnt(2)
    v_mfma_f32_16x16x32_bf16 v[224:227], v[160:163], v[44:47], 0
    s_waitcnt lgkmcnt(1)
    v_mfma_f32_16x16x32_bf16 v[228:231], v[164:167], v[44:47], 0
    s_waitcnt lgkmcnt(0)
    v_mfma_f32_16x16x32_bf16 v[232:235], v[168:171], v[44:47], 0
    s_add_u32 m0, s41, 16384
    s_mov_b32 s36, 98304
    buffer_load_dwordx4 v14, s[20:23], s36 offen offset:0 nt lds
    buffer_load_dwordx4 v15, s[20:23], s36 offen offset:1024 nt lds
    buffer_load_dwordx4 v14, s[20:23], s36 offen offset:2048 nt lds
    buffer_load_dwordx4 v15, s[20:23], s36 offen offset:3072 nt lds
    s_add_u32 m0, s41, 20480
    s_mov_b32 s36, 114688
    buffer_load_dwordx4 v14, s[20:23], s36 offen offset:0 nt lds
    buffer_load_dwordx4 v15, s[20:23], s36 offen offset:1024 nt lds
    buffer_load_dwordx4 v14, s[20:23], s36 offen offset:2048 nt lds
    buffer_load_dwordx4 v15, s[20:23], s36 offen offset:3072 nt lds
    s_mov_b64 exec, 0xff
    ds_write_b32 v252, v236 offset:256
    s_mov_b64 exec, -1
    s_waitcnt vmcnt(20)
    ds_read_b64_tr_b16 v[172:173], v20 offset:0
    ds_read_b64_tr_b16 v[176:177], v21 offset:0
    ds_read_b64_tr_b16 v[180:181], v22 offset:0
    ds_read_b64_tr_b16 v[184:185], v23 offset:0
    ds_read_b64_tr_b16 v[188:189], v24 offset:0
    ds_read_b64_tr_b16 v[192:193], v25 offset:0
    ds_read_b64_tr_b16 v[196:197], v26 offset:0
    ds_read_b64_tr_b16 v[200:201], v27 offset:0
    s_waitcnt vmcnt(16)
    ds_read_b64_tr_b16 v[174:175], v20 offset:4096
    ds_read_b64_tr_b16 v[178:179], v21 offset:4096
    ds_read_b64_tr_b16 v[182:183], v22 offset:4096
    ds_read_b64_tr_b16 v[186:187], v23 offset:4096
    ds_read_b64_tr_b16 v[190:191], v24 offset:4096
    ds_read_b64_tr_b16 v[194:195], v25 offset:4096
    ds_read_b64_tr_b16 v[198:199], v26 offset:4096
    ds_read_b64_tr_b16 v[202:203], v27 offset:4096
    s_waitcnt lgkmcnt(7)
    v_mfma_f32_16x16x32_bf16 v[204:207], v[172:175], v[52:55], v[204:207]
    s_waitcnt lgkmcnt(6)
    v_mfma_f32_16x16x32_bf16 v[208:211], v[176:179], v[52:55], v[208:211]
    s_waitcnt lgkmcnt(5)
    v_mfma_f32_16x16x32_bf16 v[212:215], v[180:183], v[52:55], v[212:215]
    s_waitcnt lgkmcnt(4)
    v_mfma_f32_16x16x32_bf16 v[216:219], v[184:187], v[52:55], v[216:219]
    s_waitcnt lgkmcnt(3)
    v_mfma_f32_16x16x32_bf16 v[220:223], v[188:191], v[52:55], v[220:223]
    s_waitcnt lgkmcnt(2)
    v_mfma_f32_16x16x32_bf16 v[224:227], v[192:195], v[52:55], v[224:227]
    s_waitcnt lgkmcnt(1)
    v_mfma_f32_16x16x32_bf16 v[228:231], v[196:199], v[52:55], v[228:231]
    s_waitcnt lgkmcnt(0)
    v_mfma_f32_16x16x32_bf16 v[232:235], v[200:203], v[52:55], v[232:235]
    s_add_u32 m0, s41, 0
    s_mov_b32 s36, 131072
    buffer_load_dwordx4 v14, s[20:23], s36 offen offset:0 nt lds
    buffer_load_dwordx4 v15, s[20:23], s36 offen offset:1024 nt lds
    buffer_load_dwordx4 v14, s[20:23], s36 offen offset:2048 nt lds
    buffer_load_dwordx4 v15, s[20:23], s36 offen offset:3072 nt lds
    s_add_u32 m0, s41, 4096
    s_mov_b32 s36, 147456
    buffer_load_dwordx4 v14, s[20:23], s36 offen offset:0 nt lds
    buffer_load_dwordx4 v15, s[20:23], s36 offen offset:1024 nt lds
    buffer_load_dwordx4 v14, s[20:23], s36 offen offset:2048 nt lds
    buffer_load_dwordx4 v15, s[20:23], s36 offen offset:3072 nt lds
    s_waitcnt vmcnt(20)
    ds_read_b64_tr_b16 v[140:141], v20 offset:8192
    ds_read_b64_tr_b16 v[144:145], v21 offset:8192
    ds_read_b64_tr_b16 v[148:149], v22 offset:8192
    ds_read_b64_tr_b16 v[152:153], v23 offset:8192
    ds_read_b64_tr_b16 v[156:157], v24 offset:8192
    ds_read_b64_tr_b16 v[160:161], v25 offset:8192
    ds_read_b64_tr_b16 v[164:165], v26 offset:8192
    ds_read_b64_tr_b16 v[168:169], v27 offset:8192
    s_waitcnt vmcnt(16)
    ds_read_b64_tr_b16 v[142:143], v20 offset:12288
    ds_read_b64_tr_b16 v[146:147], v21 offset:12288
    ds_read_b64_tr_b16 v[150:151], v22 offset:12288
    ds_read_b64_tr_b16 v[154:155], v23 offset:12288
    ds_read_b64_tr_b16 v[158:159], v24 offset:12288
    ds_read_b64_tr_b16 v[162:163], v25 offset:12288
    ds_read_b64_tr_b16 v[166:167], v26 offset:12288
    ds_read_b64_tr_b16 v[170:171], v27 offset:12288
    s_waitcnt lgkmcnt(7)
    v_mfma_f32_16x16x32_bf16 v[204:207], v[140:143], v[60:63], v[204:207]
    s_waitcnt lgkmcnt(6)
    v_mfma_f32_16x16x32_bf16 v[208:211], v[144:147], v[60:63], v[208:211]
    s_waitcnt lgkmcnt(5)
    v_mfma_f32_16x16x32_bf16 v[212:215], v[148:151], v[60:63], v[212:215]
    s_waitcnt lgkmcnt(4)
    v_mfma_f32_16x16x32_bf16 v[216:219], v[152:155], v[60:63], v[216:219]
    s_waitcnt lgkmcnt(3)
    v_mfma_f32_16x16x32_bf16 v[220:223], v[156:159], v[60:63], v[220:223]
    s_waitcnt lgkmcnt(2)
    v_mfma_f32_16x16x32_bf16 v[224:227], v[160:163], v[60:63], v[224:227]
    s_waitcnt lgkmcnt(1)
    v_mfma_f32_16x16x32_bf16 v[228:231], v[164:167], v[60:63], v[228:231]
    s_waitcnt lgkmcnt(0)
    v_mfma_f32_16x16x32_bf16 v[232:235], v[168:171], v[60:63], v[232:235]
    s_add_u32 m0, s41, 8192
    s_mov_b32 s36, 163840
    buffer_load_dwordx4 v14, s[20:23], s36 offen offset:0 nt lds
    buffer_load_dwordx4 v15, s[20:23], s36 offen offset:1024 nt lds
    buffer_load_dwordx4 v14, s[20:23], s36 offen offset:2048 nt lds
    buffer_load_dwordx4 v15, s[20:23], s36 offen offset:3072 nt lds
    s_add_u32 m0, s41, 12288
    s_mov_b32 s36, 180224
    buffer_load_dwordx4 v14, s[20:23], s36 offen offset:0 nt lds
    buffer_load_dwordx4 v15, s[20:23], s36 offen offset:1024 nt lds
    buffer_load_dwordx4 v14, s[20:23], s36 offen offset:2048 nt lds
    buffer_load_dwordx4 v15, s[20:23], s36 offen offset:3072 nt lds
    s_waitcnt vmcnt(20)
    ds_read_b64_tr_b16 v[172:173], v20 offset:16384
    ds_read_b64_tr_b16 v[176:177], v21 offset:16384
    ds_read_b64_tr_b16 v[180:181], v22 offset:16384
    ds_read_b64_tr_b16 v[184:185], v23 offset:16384
    ds_read_b64_tr_b16 v[188:189], v24 offset:16384
    ds_read_b64_tr_b16 v[192:193], v25 offset:16384
    ds_read_b64_tr_b16 v[196:197], v26 offset:16384
    ds_read_b64_tr_b16 v[200:201], v27 offset:16384
    s_waitcnt vmcnt(16)
    ds_read_b64_tr_b16 v[174:175], v20 offset:20480
    ds_read_b64_tr_b16 v[178:179], v21 offset:20480
    ds_read_b64_tr_b16 v[182:183], v22 offset:20480
    ds_read_b64_tr_b16 v[186:187], v23 offset:20480
    ds_read_b64_tr_b16 v[190:191], v24 offset:20480
    ds_read_b64_tr_b16 v[194:195], v25 offset:20480
    ds_read_b64_tr_b16 v[198:199], v26 offset:20480
    ds_read_b64_tr_b16 v[202:203], v27 offset:20480
    s_waitcnt lgkmcnt(7)
    v_mfma_f32_16x16x32_bf16 v[204:207], v[172:175], v[68:71], v[204:207]
    s_waitcnt lgkmcnt(6)
    v_mfma_f32_16x16x32_bf16 v[208:211], v[176:179], v[68:71], v[208:211]
    s_waitcnt lgkmcnt(5)
    v_mfma_f32_16x16x32_bf16 v[212:215], v[180:183], v[68:71], v[212:215]
    s_waitcnt lgkmcnt(4)
    v_mfma_f32_16x16x32_bf16 v[216:219], v[184:187], v[68:71], v[216:219]
    s_waitcnt lgkmcnt(3)
    v_mfma_f32_16x16x32_bf16 v[220:223], v[188:191], v[68:71], v[220:223]
    s_waitcnt lgkmcnt(2)
    v_mfma_f32_16x16x32_bf16 v[224:227], v[192:195], v[68:71], v[224:227]
    s_waitcnt lgkmcnt(1)
    v_mfma_f32_16x16x32_bf16 v[228:231], v[196:199], v[68:71], v[228:231]
    s_waitcnt lgkmcnt(0)
    v_mfma_f32_16x16x32_bf16 v[232:235], v[200:203], v[68:71], v[232:235]
    s_add_u32 m0, s41, 16384
    s_mov_b32 s36, 196608
    buffer_load_dwordx4 v14, s[20:23], s36 offen offset:0 nt lds
    buffer_load_dwordx4 v15, s[20:23], s36 offen offset:1024 nt lds
    buffer_load_dwordx4 v14, s[20:23], s36 offen offset:2048 nt lds
    buffer_load_dwordx4 v15, s[20:23], s36 offen offset:3072 nt lds
    s_add_u32 m0, s41, 20480
    s_mov_b32 s36, 212992
    buffer_load_dwordx4 v14, s[20:23], s36 offen offset:0 nt lds
    buffer_load_dwordx4 v15, s[20:23], s36 offen offset:1024 nt lds
    buffer_load_dwordx4 v14, s[20:23], s36 offen offset:2048 nt lds
    buffer_load_dwordx4 v15, s[20:23], s36 offen offset:3072 nt lds
    s_waitcnt vmcnt(20)
    ds_read_b64_tr_b16 v[140:141], v20 offset:0
    ds_read_b64_tr_b16 v[144:145], v21 offset:0
    ds_read_b64_tr_b16 v[148:149], v22 offset:0
    ds_read_b64_tr_b16 v[152:153], v23 offset:0
    ds_read_b64_tr_b16 v[156:157], v24 offset:0
    ds_read_b64_tr_b16 v[160:161], v25 offset:0
    ds_read_b64_tr_b16 v[164:165], v26 offset:0
    ds_read_b64_tr_b16 v[168:169], v27 offset:0
    s_waitcnt vmcnt(16)
    ds_read_b64_tr_b16 v[142:143], v20 offset:4096
    ds_read_b64_tr_b16 v[146:147], v21 offset:4096
    ds_read_b64_tr_b16 v[150:151], v22 offset:4096
    ds_read_b64_tr_b16 v[154:155], v23 offset:4096
    ds_read_b64_tr_b16 v[158:159], v24 offset:4096
    ds_read_b64_tr_b16 v[162:163], v25 offset:4096
    ds_read_b64_tr_b16 v[166:167], v26 offset:4096
    ds_read_b64_tr_b16 v[170:171], v27 offset:4096
    s_waitcnt lgkmcnt(7)
    v_mfma_f32_16x16x32_bf16 v[204:207], v[140:143], v[76:79], v[204:207]
    s_waitcnt lgkmcnt(6)
    v_mfma_f32_16x16x32_bf16 v[208:211], v[144:147], v[76:79], v[208:211]
    s_waitcnt lgkmcnt(5)
    v_mfma_f32_16x16x32_bf16 v[212:215], v[148:151], v[76:79], v[212:215]
    s_waitcnt lgkmcnt(4)
    v_mfma_f32_16x16x32_bf16 v[216:219], v[152:155], v[76:79], v[216:219]
    s_waitcnt lgkmcnt(3)
    v_mfma_f32_16x16x32_bf16 v[220:223], v[156:159], v[76:79], v[220:223]
    s_waitcnt lgkmcnt(2)
    v_mfma_f32_16x16x32_bf16 v[224:227], v[160:163], v[76:79], v[224:227]
    s_waitcnt lgkmcnt(1)
    v_mfma_f32_16x16x32_bf16 v[228:231], v[164:167], v[76:79], v[228:231]
    s_waitcnt lgkmcnt(0)
    v_mfma_f32_16x16x32_bf16 v[232:235], v[168:171], v[76:79], v[232:235]
    s_add_u32 m0, s41, 0
    s_mov_b32 s36, 229376
    buffer_load_dwordx4 v14, s[20:23], s36 offen offset:0 nt lds
    buffer_load_dwordx4 v15, s[20:23], s36 offen offset:1024 nt lds
    buffer_load_dwordx4 v14, s[20:23], s36 offen offset:2048 nt lds
    buffer_load_dwordx4 v15, s[20:23], s36 offen offset:3072 nt lds
    s_cmp_lg_u32 s38, 0
    s_cbranch_scc1 L_w3
    global_load_dwordx2 v[248:249], v8, s[12:13] sc1
L_w3:
    s_add_u32 m0, s41, 4096
    s_mov_b32 s36, 245760
    buffer_load_dwordx4 v14, s[20:23], s36 offen offset:0 nt lds
    buffer_load_dwordx4 v15, s[20:23], s36 offen offset:1024 nt lds
    buffer_load_dwordx4 v14, s[20:23], s36 offen offset:2048 nt lds
    buffer_load_dwordx4 v15, s[20:23], s36 offen offset:3072 nt lds
    s_waitcnt lgkmcnt(0)
    s_barrier
    s_cmp_lg_u32 s38, 3
    s_cbranch_scc1 L_w4
    ds_read_b128 v[36:39], v253 offset:256
    v_mov_b32 v40, v5
    v_mov_b32 v42, 0
    v_mov_b32 v43, 0
    s_mov_b32 s3, 2097152
    s_waitcnt lgkmcnt(0)
    v_add_f32 v36, v36, v37
    v_add_f32 v38, v38, v39
    v_add_f32 v41, v36, v38
    s_mov_b64 exec, 0xff
    buffer_store_dwordx4 v[40:43], v7, s[28:31], 0 offen
    s_mov_b64 exec, -1
L_w4:
    s_waitcnt vmcnt(20)
    ds_read_b64_tr_b16 v[172:173], v20 offset:8192
    ds_read_b64_tr_b16 v[176:177], v21 offset:8192
    ds_read_b64_tr_b16 v[180:181], v22 offset:8192
    ds_read_b64_tr_b16 v[184:185], v23 offset:8192
    ds_read_b64_tr_b16 v[188:189], v24 offset:8192
    ds_read_b64_tr_b16 v[192:193], v25 offset:8192
    ds_read_b64_tr_b16 v[196:197], v26 offset:8192
    ds_read_b64_tr_b16 v[200:201], v27 offset:8192
    s_waitcnt vmcnt(16)
    ds_read_b64_tr_b16 v[174:175], v20 offset:12288
    ds_read_b64_tr_b16 v[178:179], v21 offset:12288
    ds_read_b64_tr_b16 v[182:183], v22 offset:12288
    ds_read_b64_tr_b16 v[186:187], v23 offset:12288
    ds_read_b64_tr_b16 v[190:191], v24 offset:12288
    ds_read_b64_tr_b16 v[194:195], v25 offset:12288
    ds_read_b64_tr_b16 v[198:199], v26 offset:12288
    ds_read_b64_tr_b16 v[202:203], v27 offset:12288
    s_waitcnt lgkmcnt(7)
    v_mfma_f32_16x16x32_bf16 v[204:207], v[172:175], v[84:87], v[204:207]
    s_waitcnt lgkmcnt(6)
    v_mfma_f32_16x16x32_bf16 v[208:211], v[176:179], v[84:87], v[208:211]
    s_waitcnt lgkmcnt(5)
    v_mfma_f32_16x16x32_bf16 v[212:215], v[180:183], v[84:87], v[212:215]
    s_waitcnt lgkmcnt(4)
    v_mfma_f32_16x16x32_bf16 v[216:219], v[184:187], v[84:87], v[216:219]
    s_waitcnt lgkmcnt(3)
    v_mfma_f32_16x16x32_bf16 v[220:223], v[188:191], v[84:87], v[220:223]
    s_waitcnt lgkmcnt(2)
    v_mfma_f32_16x16x32_bf16 v[224:227], v[192:195], v[84:87], v[224:227]
    s_waitcnt lgkmcnt(1)
    v_mfma_f32_16x16x32_bf16 v[228:231], v[196:199], v[84:87], v[228:231]
    s_waitcnt lgkmcnt(0)
    v_mfma_f32_16x16x32_bf16 v[232:235], v[200:203], v[84:87], v[232:235]
    s_waitcnt vmcnt(12)
    ds_read_b64_tr_b16 v[140:141], v20 offset:16384
    ds_read_b64_tr_b16 v[144:145], v21 offset:16384
    ds_read_b64_tr_b16 v[148:149], v22 offset:16384
    ds_read_b64_tr_b16 v[152:153], v23 offset:16384
    ds_read_b64_tr_b16 v[156:157], v24 offset:16384
    ds_read_b64_tr_b16 v[160:161], v25 offset:16384
    ds_read_b64_tr_b16 v[164:165], v26 offset:16384
    ds_read_b64_tr_b16 v[168:169], v27 offset:16384
    s_waitcnt vmcnt(8)
    ds_read_b64_tr_b16 v[142:143], v20 offset:20480
    ds_read_b64_tr_b16 v[146:147], v21 offset:20480
    ds_read_b64_tr_b16 v[150:151], v22 offset:20480
    ds_read_b64_tr_b16 v[154:155], v23 offset:20480
    ds_read_b64_tr_b16 v[158:159], v24 offset:20480
    ds_read_b64_tr_b16 v[162:163], v25 offset:20480
    ds_read_b64_tr_b16 v[166:167], v26 offset:20480
    ds_read_b64_tr_b16 v[170:171], v27 offset:20480
    s_waitcnt lgkmcnt(7)
    v_mfma_f32_16x16x32_bf16 v[204:207], v[140:143], v[92:95], v[204:207]
    s_waitcnt lgkmcnt(6)
    v_mfma_f32_16x16x32_bf16 v[208:211], v[144:147], v[92:95], v[208:211]
    s_waitcnt lgkmcnt(5)
    v_mfma_f32_16x16x32_bf16 v[212:215], v[148:151], v[92:95], v[212:215]
    s_waitcnt lgkmcnt(4)
    v_mfma_f32_16x16x32_bf16 v[216:219], v[152:155], v[92:95], v[216:219]
    s_waitcnt lgkmcnt(3)
    v_mfma_f32_16x16x32_bf16 v[220:223], v[156:159], v[92:95], v[220:223]
    s_waitcnt lgkmcnt(2)
    v_mfma_f32_16x16x32_bf16 v[224:227], v[160:163], v[92:95], v[224:227]
    s_waitcnt lgkmcnt(1)
    v_mfma_f32_16x16x32_bf16 v[228:231], v[164:167], v[92:95], v[228:231]
    s_waitcnt lgkmcnt(0)
    v_mfma_f32_16x16x32_bf16 v[232:235], v[168:171], v[92:95], v[232:235]
    buffer_load_dwordx4 v[108:111], v6, s[28:31], 0 offen
    s_cmp_lt_u32 s40, 24
    s_cselect_b32 s3, 0x40000000, 0
    v_add_u32 v121, s3, v255
    v_add_u32 v122, s3, v254
    buffer_load_dword v112, v121, s[28:31], s50 offen
    buffer_load_dword v113, v121, s[28:31], s51 offen
    buffer_load_dword v114, v121, s[28:31], s52 offen
    buffer_load_dword v115, v121, s[28:31], s53 offen
    buffer_load_dword v116, v122, s[28:31], s50 offen
    buffer_load_dword v117, v122, s[28:31], s51 offen
    buffer_load_dword v118, v122, s[28:31], s52 offen
    buffer_load_dword v119, v122, s[28:31], s53 offen
    s_waitcnt vmcnt(13)
    ds_read_b64_tr_b16 v[172:173], v20 offset:0
    ds_read_b64_tr_b16 v[188:189], v24 offset:0
    ds_read_b64_tr_b16 v[176:177], v21 offset:0
    ds_read_b64_tr_b16 v[192:193], v25 offset:0
    ds_read_b64_tr_b16 v[180:181], v22 offset:0
    ds_read_b64_tr_b16 v[196:197], v26 offset:0
    ds_read_b64_tr_b16 v[184:185], v23 offset:0
    ds_read_b64_tr_b16 v[200:201], v27 offset:0
    s_waitcnt vmcnt(9)
    ds_read_b64_tr_b16 v[174:175], v20 offset:4096
    ds_read_b64_tr_b16 v[190:191], v24 offset:4096
    ds_read_b64_tr_b16 v[178:179], v21 offset:4096
    ds_read_b64_tr_b16 v[194:195], v25 offset:4096
    ds_read_b64_tr_b16 v[182:183], v22 offset:4096
    ds_read_b64_tr_b16 v[198:199], v26 offset:4096
    ds_read_b64_tr_b16 v[186:187], v23 offset:4096
    ds_read_b64_tr_b16 v[202:203], v27 offset:4096
    v_lshrrev_b64 v[248:249], s47, v[248:249]
    v_and_b32 v248, 0xff, v248
    s_mov_b64 exec, 1
    ds_write_b32 v252, v248 offset:384
    s_mov_b64 exec, -1
    s_waitcnt lgkmcnt(8)
    v_mfma_f32_16x16x32_bf16 v[204:207], v[172:175], v[100:103], v[204:207]
    s_waitcnt lgkmcnt(7)
    v_mfma_f32_16x16x32_bf16 v[220:223], v[188:191], v[100:103], v[220:223]
    s_waitcnt lgkmcnt(6)
    v_mfma_f32_16x16x32_bf16 v[208:211], v[176:179], v[100:103], v[208:211]
    s_waitcnt lgkmcnt(5)
    v_mfma_f32_16x16x32_bf16 v[224:227], v[192:195], v[100:103], v[224:227]
    s_waitcnt lgkmcnt(4)
    v_mfma_f32_16x16x32_bf16 v[212:215], v[180:183], v[100:103], v[212:215]
    s_waitcnt lgkmcnt(3)
    v_mfma_f32_16x16x32_bf16 v[228:231], v[196:199], v[100:103], v[228:231]
    v_cndmask_b32 v124, v204, v220, s[44:45]
    v_cndmask_b32 v125, v205, v221, s[44:45]
    v_cndmask_b32 v126, v206, v222, s[44:45]
    v_cndmask_b32 v127, v207, v223, s[44:45]
    ds_write_b128 v250, v[124:127] offset:0
    s_waitcnt lgkmcnt(3)
    v_mfma_f32_16x16x32_bf16 v[216:219], v[184:187], v[100:103], v[216:219]
    s_waitcnt lgkmcnt(2)
    v_mfma_f32_16x16x32_bf16 v[232:235], v[200:203], v[100:103], v[232:235]
    v_cndmask_b32 v128, v208, v224, s[44:45]
    v_cndmask_b32 v129, v209, v225, s[44:45]
    v_cndmask_b32 v130, v210, v226, s[44:45]
    v_cndmask_b32 v131, v211, v227, s[44:45]
    ds_write_b128 v250, v[128:131] offset:64
    v_cndmask_b32 v132, v212, v228, s[44:45]
    v_cndmask_b32 v133, v213, v229, s[44:45]
    v_cndmask_b32 v134, v214, v230, s[44:45]
    v_cndmask_b32 v135, v215, v231, s[44:45]
    ds_write_b128 v250, v[132:135] offset:128
    v_cndmask_b32 v136, v216, v232, s[44:45]
    v_cndmask_b32 v137, v217, v233, s[44:45]
    v_cndmask_b32 v138, v218, v234, s[44:45]
    v_cndmask_b32 v139, v219, v235, s[44:45]
    ds_write_b128 v250, v[136:139] offset:192
    s_waitcnt lgkmcnt(0)
    s_barrier
    ds_read_b32 v9, v3 offset:384
    ds_read_b128 v[140:143], v251 offset:8192
    ds_read_b128 v[144:147], v251 offset:32768
    ds_read_b128 v[148:151], v251 offset:57344
    ds_read_b128 v[152:155], v31
    s_mov_b32 s46, 0
    s_waitcnt lgkmcnt(2)
    v_readfirstlane_b32 s43, v9
    v_add_f32 v140, v140, v144
    v_add_f32 v141, v141, v145
    v_add_f32 v142, v142, v146
    v_add_f32 v143, v143, v147
    s_cmp_eq_u32 s43, 32
    s_waitcnt lgkmcnt(0)
    v_add_f32 v148, v148, v152
    v_add_f32 v149, v149, v153
    v_add_f32 v150, v150, v154
    v_add_f32 v151, v151, v155
    v_add_f32 v140, v140, v148
    v_add_f32 v141, v141, v149
    v_add_f32 v142, v142, v150
    v_add_f32 v143, v143, v151
    buffer_store_dwordx4 v[140:143], v6, s[28:31], 0 offen
    s_cbranch_scc0 L_slowpub
    s_cmp_lt_u32 s40, 24
    s_cbranch_scc1 L_fin
L_poll:
    buffer_load_dwordx2 v[44:45], v255, s[28:31], s50 offen sc1
    buffer_load_dwordx2 v[46:47], v255, s[28:31], s51 offen sc1
    buffer_load_dwordx2 v[48:49], v255, s[28:31], s52 offen sc1
    buffer_load_dwordx2 v[50:51], v255, s[28:31], s53 offen sc1
    buffer_load_dwordx4 v[52:55], v254, s[28:31], s50 offen sc1
    buffer_load_dwordx4 v[56:59], v254, s[28:31], s51 offen sc1
    buffer_load_dwordx4 v[60:63], v254, s[28:31], s52 offen sc1
    buffer_load_dwordx4 v[64:67], v254, s[28:31], s53 offen sc1
    s_add_u32 s46, s46, 1
    s_waitcnt vmcnt(4)
    v_max3_u32 v9, v44, v45, v46
    v_max3_u32 v9, v9, v47, v48
    v_max3_u32 v9, v9, v49, v50
    v_max_u32 v9, v9, v51
    v_max3_f32 v4, v44, v46, v48
    v_cmp_eq_u32 vcc, -1, v9
    v_max_f32 v4, v4, v50
    s_cmp_ge_u32 s46, 0x40000
    s_cbranch_scc1 L_wts
    s_cmp_lg_u64 vcc, 0
    s_cbranch_scc0 L_wts
    s_waitcnt vmcnt(0)
    s_branch L_poll
L_wts:
    v_max_f32_dpp v4, v4, v4 row_ror:8 row_mask:0xf bank_mask:0xf
    v_mov_b32 v9, v4
    s_nop 1
    v_permlane16_swap_b32 v9, v4
    v_max_f32 v4, v4, v9
    v_mov_b32 v9, v4
    s_nop 1
    v_permlane32_swap_b32 v9, v4
    v_max_f32 v4, v4, v9
    v_sub_f32 v44, v44, v4
    v_sub_f32 v46, v46, v4
    v_sub_f32 v48, v48, v4
    v_sub_f32 v50, v50, v4
    v_exp_f32 v44, v44
    v_exp_f32 v46, v46
    v_exp_f32 v48, v48
    v_exp_f32 v50, v50
    v_mul_f32 v5, v44, v45
    v_fmac_f32 v5, v46, v47
    v_fmac_f32 v5, v48, v49
    v_fmac_f32 v5, v50, v51
    s_nop 1
    v_add_f32_dpp v5, v5, v5 row_ror:8 row_mask:0xf bank_mask:0xf
    v_mov_b32 v9, v5
    s_nop 1
    v_permlane16_swap_b32 v9, v5
    v_add_f32 v5, v5, v9
    v_mov_b32 v9, v5
    s_nop 1
    v_permlane32_swap_b32 v9, v5
    v_add_f32 v5, v5, v9
    v_rcp_f32 v5, v5
    s_nop 0
    v_mul_f32 v44, v44, v5
    v_mul_f32 v46, v46, v5
    v_mul_f32 v48, v48, v5
    v_mul_f32 v50, v50, v5
L_chk:
    s_waitcnt vmcnt(2)
    v_max3_u32 v9, v52, v53, v54
    v_max3_u32 v4, v55, v56, v57
    v_max3_u32 v9, v9, v58, v59
    s_waitcnt vmcnt(0)
    v_max3_u32 v4, v4, v60, v61
    v_max3_u32 v9, v9, v62, v63
    v_max3_u32 v4, v4, v64, v65
    v_max3_u32 v9, v9, v66, v67
    v_max_u32 v9, v9, v4
    v_cmp_eq_u32 vcc, -1, v9
    v_mul_f32 v68, v44, v52
    v_mul_f32 v69, v44, v53
    v_mul_f32 v70, v44, v54
    v_mul_f32 v71, v44, v55
    s_and_b64 exec, exec, vcc
    s_cbranch_scc0 L_comb
    buffer_load_dwordx4 v[52:55], v254, s[28:31], s50 offen sc1
    buffer_load_dwordx4 v[56:59], v254, s[28:31], s51 offen sc1
    buffer_load_dwordx4 v[60:63], v254, s[28:31], s52 offen sc1
    buffer_load_dwordx4 v[64:67], v254, s[28:31], s53 offen sc1
    s_add_u32 s46, s46, 1
    s_cmp_lt_u32 s46, 0x40000
    s_cbranch_scc1 L_chk
    s_waitcnt vmcnt(0)
L_comb:
    s_mov_b64 exec, -1
    v_fmac_f32 v68, v46, v56
    v_fmac_f32 v69, v46, v57
    v_fmac_f32 v70, v46, v58
    v_fmac_f32 v71, v46, v59
    v_fmac_f32 v68, v48, v60
    v_fmac_f32 v69, v48, v61
    v_fmac_f32 v70, v48, v62
    v_fmac_f32 v71, v48, v63
    v_fmac_f32 v68, v50, v64
    v_fmac_f32 v69, v50, v65
    v_fmac_f32 v70, v50, v66
    v_fmac_f32 v71, v50, v67
    s_nop 0
    v_permlane32_swap_b32 v68, v70
    v_permlane32_swap_b32 v69, v71
    v_add_f32 v68, v68, v70
    v_add_f32 v69, v69, v71
    s_nop 1
    v_permlane16_swap_b32 v68, v69
    v_add_f32 v68, v68, v69
    s_nop 1
    v_add_f32_dpp v68, v68, v68 row_ror:8 row_mask:0xf bank_mask:0xf
    s_mov_b32 exec_lo, 0x00ff00ff
    s_mov_b32 exec_hi, 0x00ff00ff
    v_cvt_pk_bf16_f32 v68, v68, v68
    buffer_store_short v68, v246, s[32:35], 0 offen
L_fin:
L_end:
    s_endpgm
L_slowpub:
    s_mov_b32 s36, 2097152
    buffer_store_dwordx4 v[140:143], v6, s[28:31], s36 offen sc1
    s_cmp_lg_u32 s38, 3
    s_cbranch_scc1 L_w5
    s_mov_b64 exec, 0xff
    buffer_store_dwordx4 v[40:43], v7, s[28:31], s36 offen sc1
    s_mov_b64 exec, -1
L_w5:
    s_waitcnt vmcnt(0)
    s_barrier
    s_cmp_lg_u32 s38, 0
    s_cbranch_scc1 L_w6
    v_mov_b32 v9, 1
    s_mov_b64 exec, 1
    global_atomic_add v4, v8, v9, s[12:13] offset:128 sc0
    s_mov_b64 exec, -1
L_st:
    global_load_dwordx2 v[248:249], v8, s[12:13] sc1
    s_add_u32 s46, s46, 1
    s_mov_b32 s54, 0
    s_waitcnt vmcnt(0)
    v_readfirstlane_b32 s42, v4
    v_sad_u8 v9, v248, 0, 0
    v_sad_u8 v9, v249, 0, v9
    v_lshrrev_b64 v[248:249], s47, v[248:249]
    v_and_b32 v248, 0xff, v248
    v_readfirstlane_b32 s48, v9
    s_nop 0
    v_readfirstlane_b32 s43, v248
    s_max_u32 s3, s42, s40
    s_cmp_lt_u32 s3, 24
    s_cbranch_scc1 L_s3
    s_cmp_ge_u32 s46, 0x40000
    s_cbranch_scc1 L_s1
    s_cmp_lt_u32 s48, 32
    s_cbranch_scc1 L_st
L_s1:
    s_add_u32 s54, s42, 32
    s_cmp_eq_u32 s43, 32
    s_cselect_b32 s54, s40, s54
    s_cmp_lt_u32 s54, 56
    s_cbranch_scc1 L_s3
    s_cmp_ge_u32 s54, 63
    s_cbranch_scc1 L_s3
    s_mov_b32 s46, 0
L_s2:
    global_load_dword v9, v8, s[12:13] offset:128 sc1
    s_add_u32 s46, s46, 1
    s_waitcnt vmcnt(0)
    v_readfirstlane_b32 s3, v9
    s_nop 3
    s_cmp_ge_u32 s46, 0x40000
    s_cbranch_scc1 L_s3
    s_cmp_lt_u32 s3, 32
    s_cbranch_scc1 L_s2
L_s3:
    v_mov_b32 v9, s54
    ds_write_b32 v3, v9 offset:400
    s_waitcnt lgkmcnt(0)
L_w6:
    s_barrier
    ds_read_b32 v9, v3 offset:400
    s_waitcnt lgkmcnt(0)
    v_readfirstlane_b32 s54, v9
    s_mov_b32 s46, 0
    s_nop 2
    s_and_b32 s3, s54, 31
    s_cmp_lt_u32 s3, 24
    s_cbranch_scc1 L_fin
    s_cmp_lt_u32 s54, 32
    s_cbranch_scc1 L_poll
    s_and_b32 s54, s54, 7
    s_mul_i32 s3, s39, 139264
    v_lshrrev_b32 v9, 3, v1
    v_mul_u32_u24 v9, 4352, v9
    v_add_u32 v9, s3, v9
    s_lshl_b32 s3, s54, 9
    s_lshl_b32 s48, s38, 7
    s_add_u32 s3, s3, s48
    v_and_b32 v246, 7, v1
    v_lshl_add_u32 v254, v246, 4, v9
    v_add_u32 v254, s3, v254
    s_lshl_b32 s3, s54, 4
    s_add_u32 s3, s3, 4096
    v_add_u32 v255, s3, v9
    s_lshl_b32 s3, s39, 3
    s_add_u32 s3, s3, s54
    s_lshl_b32 s3, s3, 8
    s_lshl_b32 s48, s38, 6
    s_add_u32 s3, s3, s48
    v_lshlrev_b32 v246, 3, v246
    v_lshl_or_b32 v246, v2, 1, v246
    v_add_u32 v246, s3, v246
    s_add_u32 s50, s50, 2097152
    s_add_u32 s51, s51, 2097152
    s_add_u32 s52, s52, 2097152
    s_add_u32 s53, s53, 2097152
    s_branch L_poll
.section .rodata,"a"
.p2align 6
.amdhsa_kernel standalone__gqa_softmax__decode_kernel
  .amdhsa_next_free_vgpr 256
  .amdhsa_next_free_sgpr 56
  .amdhsa_accum_offset 256
  .amdhsa_group_segment_fixed_size 0
  .amdhsa_kernarg_size 48
  .amdhsa_user_sgpr_count 2
  .amdhsa_user_sgpr_kernarg_segment_ptr 1
  .amdhsa_system_sgpr_workgroup_id_x 1
.end_amdhsa_kernel
```
